```python
import torch

def _softmax(x, axis=-1):
    return torch.softmax(x, dim=axis)
def _gelu(x):
    return torch.nn.functional.gelu(x, approximate="tanh")
def _silu(x):
    return torch.nn.functional.silu(x)
def _sigmoid(x):
    return torch.sigmoid(x)
def _layernorm(x, axis=-1, eps=1e-5):
    m = x.mean(dim=axis, keepdim=True)
    v = x.var(dim=axis, keepdim=True, unbiased=False)
    return (x - m) / torch.sqrt(v + eps)
def _scatter_add(tgt, idx, src, axis=0):
    return tgt.clone().index_add_(axis, idx, src)
def _segment_sum(src, seg, n):
    out = torch.zeros((n,) + src.shape[1:], dtype=src.dtype)
    return out.index_add_(0, seg, src)
def _pad(x, pw):
    flat = tuple(v for pair in reversed(pw) for v in pair)
    return torch.nn.functional.pad(x, flat)

kernel_name = 'standalone__softmax_full_bidir__sampling'

def setup_inputs():

    _w = (lambda a: (lambda t: t.to(torch.bfloat16) if t.is_floating_point() else t)(torch.as_tensor(a)))
    B, H, Sq, Skv, Dh = 8, 32, 1, 4096, 192
    return {
        "q": _w((lambda *s: torch.randn(*s, dtype=torch.bfloat16) * 0.8)(B, H, Sq, Dh)),
        "k": _w((lambda *s: torch.randn(*s, dtype=torch.bfloat16) * 0.8)(B, H, Skv, Dh)),
        "v": _w((lambda *s: torch.randn(*s, dtype=torch.bfloat16) * 0.05)(B, H, Skv, Dh)),
    }

def reference(q, k, v):
    scale = q.shape[-1] ** -0.5
    scores = torch.einsum('bhqd,bhkd->bhqk', q, k) * scale
    attn = _softmax(scores, axis=-1)
    return torch.einsum('bhqk,bhkd->bhqd', attn, v)
```

```asm
; @launch grid=(256,1,1) block=(256,1,1) lds=20000
.amdgcn_target "amdgcn-amd-amdhsa--gfx950"
.text
.globl standalone__softmax_full_bidir__sampling_kernel
.p2align 8
.type standalone__softmax_full_bidir__sampling_kernel,@function
standalone__softmax_full_bidir__sampling_kernel:
    s_cmp_ge_u32 s2, 256
    s_cbranch_scc1 L_end
    s_load_dwordx4 s[4:7], s[0:1], 0
    s_load_dwordx4 s[8:11], s[0:1], 16
    s_bitcmp1_b32 s2, 0
    s_cselect_b32 s36, 158, 0
    s_bitcmp1_b32 s2, 1
    s_cselect_b32 s3, 271, 0
    s_add_u32 s36, s36, s3
    s_bitcmp1_b32 s2, 2
    s_cselect_b32 s3, 30, 0
    s_add_u32 s36, s36, s3
    s_bitcmp1_b32 s2, 3
    s_cselect_b32 s3, 507, 0
    s_add_u32 s36, s36, s3
    s_bitcmp1_b32 s2, 4
    s_cselect_b32 s3, 18, 0
    s_add_u32 s36, s36, s3
    s_bitcmp1_b32 s2, 5
    s_cselect_b32 s3, 76, 0
    s_add_u32 s36, s36, s3
    s_bitcmp1_b32 s2, 6
    s_cselect_b32 s3, 399, 0
    s_add_u32 s36, s36, s3
    s_bitcmp1_b32 s2, 7
    s_cselect_b32 s3, 188, 0
    s_add_u32 s36, s36, s3
    v_lshrrev_b32 v5, 6, v0
    v_and_b32 v0, 63, v0
    v_readfirstlane_b32 s28, v5
    v_lshrrev_b32 v5, 3, v0
    v_and_b32 v6, 7, v0
    v_lshlrev_b32 v6, 4, v6
    v_mul_u32_u24 v1, 384, v5
    v_add_u32 v1, v1, v6
    v_mul_u32_u24 v2, 528, v5
    s_mul_i32 s32, s2, 1572864
    s_mul_i32 s33, s2, 384
    s_mul_i32 s30, s28, 3072
    s_mov_b32 s30, s36
    s_add_u32 s30, s30, s28
    s_and_b32 s30, s30, 511
    s_mul_i32 s30, s30, 3072
    s_mov_b32 s34, 1572864
    s_waitcnt lgkmcnt(0)
    s_add_u32 s20, s4, s33
    s_addc_u32 s21, s5, 0
    s_and_b32 s21, s21, 65535
    s_mov_b32 s22, 384
    s_mov_b32 s23, 131072
    s_add_u32 s12, s6, s32
    s_addc_u32 s13, s7, 0
    s_and_b32 s13, s13, 65535
    s_mov_b32 s14, 1572864
    s_mov_b32 s15, 131072
    buffer_load_dwordx4 v[36:39], v6, s[20:23], 0 offen
    buffer_load_dwordx4 v[40:43], v6, s[20:23], 0 offen offset:128
    buffer_load_dwordx4 v[44:47], v6, s[20:23], 0 offen offset:256
    buffer_load_dwordx4 v[60:63], v1, s[12:15], s30 offen nt
    buffer_load_dwordx4 v[64:67], v1, s[12:15], s30 offen offset:128 nt
    buffer_load_dwordx4 v[68:71], v1, s[12:15], s30 offen offset:256 nt
    s_add_u32 s30, s30, 12288
    s_cmp_ge_u32 s30, s34
    s_cselect_b32 s35, 1572864, 0
    s_sub_u32 s30, s30, s35
    buffer_load_dwordx4 v[72:75], v1, s[12:15], s30 offen nt
    buffer_load_dwordx4 v[76:79], v1, s[12:15], s30 offen offset:128 nt
    buffer_load_dwordx4 v[80:83], v1, s[12:15], s30 offen offset:256 nt
    s_add_u32 s30, s30, 12288
    s_cmp_ge_u32 s30, s34
    s_cselect_b32 s35, 1572864, 0
    s_sub_u32 s30, s30, s35
    buffer_load_dwordx4 v[84:87], v1, s[12:15], s30 offen nt
    buffer_load_dwordx4 v[88:91], v1, s[12:15], s30 offen offset:128 nt
    buffer_load_dwordx4 v[92:95], v1, s[12:15], s30 offen offset:256 nt
    s_add_u32 s30, s30, 12288
    s_cmp_ge_u32 s30, s34
    s_cselect_b32 s35, 1572864, 0
    s_sub_u32 s30, s30, s35
    buffer_load_dwordx4 v[96:99], v1, s[12:15], s30 offen nt
    buffer_load_dwordx4 v[100:103], v1, s[12:15], s30 offen offset:128 nt
    buffer_load_dwordx4 v[104:107], v1, s[12:15], s30 offen offset:256 nt
    s_add_u32 s30, s30, 12288
    s_cmp_ge_u32 s30, s34
    s_cselect_b32 s35, 1572864, 0
    s_sub_u32 s30, s30, s35
    buffer_load_dwordx4 v[108:111], v1, s[12:15], s30 offen nt
    buffer_load_dwordx4 v[112:115], v1, s[12:15], s30 offen offset:128 nt
    buffer_load_dwordx4 v[116:119], v1, s[12:15], s30 offen offset:256 nt
    s_add_u32 s30, s30, 12288
    s_cmp_ge_u32 s30, s34
    s_cselect_b32 s35, 1572864, 0
    s_sub_u32 s30, s30, s35
    buffer_load_dwordx4 v[120:123], v1, s[12:15], s30 offen nt
    buffer_load_dwordx4 v[124:127], v1, s[12:15], s30 offen offset:128 nt
    buffer_load_dwordx4 v[128:131], v1, s[12:15], s30 offen offset:256 nt
    s_add_u32 s30, s30, 12288
    s_cmp_ge_u32 s30, s34
    s_cselect_b32 s35, 1572864, 0
    s_sub_u32 s30, s30, s35
    buffer_load_dwordx4 v[132:135], v1, s[12:15], s30 offen nt
    buffer_load_dwordx4 v[136:139], v1, s[12:15], s30 offen offset:128 nt
    buffer_load_dwordx4 v[140:143], v1, s[12:15], s30 offen offset:256 nt
    s_add_u32 s30, s30, 12288
    s_cmp_ge_u32 s30, s34
    s_cselect_b32 s35, 1572864, 0
    s_sub_u32 s30, s30, s35
    buffer_load_dwordx4 v[144:147], v1, s[12:15], s30 offen nt
    buffer_load_dwordx4 v[148:151], v1, s[12:15], s30 offen offset:128 nt
    buffer_load_dwordx4 v[152:155], v1, s[12:15], s30 offen offset:256 nt
    s_add_u32 s30, s30, 12288
    s_cmp_ge_u32 s30, s34
    s_cselect_b32 s35, 1572864, 0
    s_sub_u32 s30, s30, s35
    s_add_u32 s16, s8, s32
    s_addc_u32 s17, s9, 0
    s_and_b32 s17, s17, 65535
    s_mov_b32 s18, 1572864
    s_mov_b32 s19, 131072
    s_add_u32 s24, s10, s33
    s_addc_u32 s25, s11, 0
    s_and_b32 s25, s25, 65535
    s_mov_b32 s26, 384
    s_mov_b32 s27, 131072
    s_mov_b32 s31, 0x3dd53b95
    s_mul_i32 s32, s28, 4224
    v_add_u32 v2, s32, v2
    v_mov_b32 v3, 0xff61b1e6
    v_mov_b32 v4, 0
    s_getreg_b32 s37, hwreg(HW_REG_XCC_ID)
    s_and_b32 s37, s37, 15
    s_lshr_b32 s37, 85, s37
    s_and_b32 s37, s37, 1
    s_mov_b32 s29, 15
L_k:
    s_waitcnt vmcnt(21)
    v_mov_b32 v8, 0
    v_mov_b32 v9, 0
    v_dot2c_f32_bf16 v8, v60, v36
    v_dot2c_f32_bf16 v9, v61, v37
    v_dot2c_f32_bf16 v8, v62, v38
    v_dot2c_f32_bf16 v9, v63, v39
    v_dot2c_f32_bf16 v8, v64, v40
    v_dot2c_f32_bf16 v9, v65, v41
    v_dot2c_f32_bf16 v8, v66, v42
    v_dot2c_f32_bf16 v9, v67, v43
    v_dot2c_f32_bf16 v8, v68, v44
    v_dot2c_f32_bf16 v9, v69, v45
    v_dot2c_f32_bf16 v8, v70, v46
    v_dot2c_f32_bf16 v9, v71, v47
    s_cmp_eq_u32 s37, 0
    s_cbranch_scc1 L_xl1
    s_waitcnt vmcnt(5)
L_xl1:
    buffer_load_dwordx4 v[60:63], v1, s[12:15], s30 offen nt
    buffer_load_dwordx4 v[64:67], v1, s[12:15], s30 offen offset:128 nt
    buffer_load_dwordx4 v[68:71], v1, s[12:15], s30 offen offset:256 nt
    s_add_u32 s30, s30, 12288
    s_cmp_ge_u32 s30, s34
    s_cselect_b32 s35, 1572864, 0
    s_sub_u32 s30, s30, s35
    s_waitcnt vmcnt(21)
    v_mov_b32 v10, 0
    v_mov_b32 v11, 0
    v_dot2c_f32_bf16 v10, v72, v36
    v_dot2c_f32_bf16 v11, v73, v37
    v_dot2c_f32_bf16 v10, v74, v38
    v_dot2c_f32_bf16 v11, v75, v39
    v_dot2c_f32_bf16 v10, v76, v40
    v_dot2c_f32_bf16 v11, v77, v41
    v_dot2c_f32_bf16 v10, v78, v42
    v_dot2c_f32_bf16 v11, v79, v43
    v_dot2c_f32_bf16 v10, v80, v44
    v_dot2c_f32_bf16 v11, v81, v45
    v_dot2c_f32_bf16 v10, v82, v46
    v_dot2c_f32_bf16 v11, v83, v47
    s_cmp_eq_u32 s37, 0
    s_cbranch_scc1 L_xl2
    s_waitcnt vmcnt(5)
L_xl2:
    buffer_load_dwordx4 v[72:75], v1, s[12:15], s30 offen nt
    buffer_load_dwordx4 v[76:79], v1, s[12:15], s30 offen offset:128 nt
    buffer_load_dwordx4 v[80:83], v1, s[12:15], s30 offen offset:256 nt
    s_add_u32 s30, s30, 12288
    s_cmp_ge_u32 s30, s34
    s_cselect_b32 s35, 1572864, 0
    s_sub_u32 s30, s30, s35
    v_add_f32 v12, v8, v9
    s_nop 1
    v_add_f32_dpp v12, v12, v12 quad_perm:[1,0,3,2] row_mask:0xf bank_mask:0xf
    s_nop 1
    v_add_f32_dpp v12, v12, v12 quad_perm:[2,3,0,1] row_mask:0xf bank_mask:0xf
    s_nop 1
    v_add_f32_dpp v12, v12, v12 row_half_mirror row_mask:0xf bank_mask:0xf
    v_max_f32 v3, v3, v12
    s_waitcnt vmcnt(21)
    v_mov_b32 v8, 0
    v_mov_b32 v9, 0
    v_dot2c_f32_bf16 v8, v84, v36
    v_dot2c_f32_bf16 v9, v85, v37
    v_dot2c_f32_bf16 v8, v86, v38
    v_dot2c_f32_bf16 v9, v87, v39
    v_dot2c_f32_bf16 v8, v88, v40
    v_dot2c_f32_bf16 v9, v89, v41
    v_dot2c_f32_bf16 v8, v90, v42
    v_dot2c_f32_bf16 v9, v91, v43
    v_dot2c_f32_bf16 v8, v92, v44
    v_dot2c_f32_bf16 v9, v93, v45
    v_dot2c_f32_bf16 v8, v94, v46
    v_dot2c_f32_bf16 v9, v95, v47
    s_cmp_eq_u32 s37, 0
    s_cbranch_scc1 L_xl3
    s_waitcnt vmcnt(5)
L_xl3:
    buffer_load_dwordx4 v[84:87], v1, s[12:15], s30 offen nt
    buffer_load_dwordx4 v[88:91], v1, s[12:15], s30 offen offset:128 nt
    buffer_load_dwordx4 v[92:95], v1, s[12:15], s30 offen offset:256 nt
    s_add_u32 s30, s30, 12288
    s_cmp_ge_u32 s30, s34
    s_cselect_b32 s35, 1572864, 0
    s_sub_u32 s30, s30, s35
    v_add_f32 v13, v10, v11
    s_nop 1
    v_add_f32_dpp v13, v13, v13 quad_perm:[1,0,3,2] row_mask:0xf bank_mask:0xf
    s_nop 1
    v_add_f32_dpp v13, v13, v13 quad_perm:[2,3,0,1] row_mask:0xf bank_mask:0xf
    s_nop 1
    v_add_f32_dpp v13, v13, v13 row_half_mirror row_mask:0xf bank_mask:0xf
    v_max_f32 v3, v3, v13
    s_waitcnt vmcnt(21)
    v_mov_b32 v10, 0
    v_mov_b32 v11, 0
    v_dot2c_f32_bf16 v10, v96, v36
    v_dot2c_f32_bf16 v11, v97, v37
    v_dot2c_f32_bf16 v10, v98, v38
    v_dot2c_f32_bf16 v11, v99, v39
    v_dot2c_f32_bf16 v10, v100, v40
    v_dot2c_f32_bf16 v11, v101, v41
    v_dot2c_f32_bf16 v10, v102, v42
    v_dot2c_f32_bf16 v11, v103, v43
    v_dot2c_f32_bf16 v10, v104, v44
    v_dot2c_f32_bf16 v11, v105, v45
    v_dot2c_f32_bf16 v10, v106, v46
    v_dot2c_f32_bf16 v11, v107, v47
    s_cmp_eq_u32 s37, 0
    s_cbranch_scc1 L_xl4
    s_waitcnt vmcnt(5)
L_xl4:
    buffer_load_dwordx4 v[96:99], v1, s[12:15], s30 offen nt
    buffer_load_dwordx4 v[100:103], v1, s[12:15], s30 offen offset:128 nt
    buffer_load_dwordx4 v[104:107], v1, s[12:15], s30 offen offset:256 nt
    s_add_u32 s30, s30, 12288
    s_cmp_ge_u32 s30, s34
    s_cselect_b32 s35, 1572864, 0
    s_sub_u32 s30, s30, s35
    v_add_f32 v14, v8, v9
    s_nop 1
    v_add_f32_dpp v14, v14, v14 quad_perm:[1,0,3,2] row_mask:0xf bank_mask:0xf
    s_nop 1
    v_add_f32_dpp v14, v14, v14 quad_perm:[2,3,0,1] row_mask:0xf bank_mask:0xf
    s_nop 1
    v_add_f32_dpp v14, v14, v14 row_half_mirror row_mask:0xf bank_mask:0xf
    v_max_f32 v3, v3, v14
    s_waitcnt vmcnt(21)
    v_mov_b32 v8, 0
    v_mov_b32 v9, 0
    v_dot2c_f32_bf16 v8, v108, v36
    v_dot2c_f32_bf16 v9, v109, v37
    v_dot2c_f32_bf16 v8, v110, v38
    v_dot2c_f32_bf16 v9, v111, v39
    v_dot2c_f32_bf16 v8, v112, v40
    v_dot2c_f32_bf16 v9, v113, v41
    v_dot2c_f32_bf16 v8, v114, v42
    v_dot2c_f32_bf16 v9, v115, v43
    v_dot2c_f32_bf16 v8, v116, v44
    v_dot2c_f32_bf16 v9, v117, v45
    v_dot2c_f32_bf16 v8, v118, v46
    v_dot2c_f32_bf16 v9, v119, v47
    s_cmp_eq_u32 s37, 0
    s_cbranch_scc1 L_xl5
    s_waitcnt vmcnt(5)
L_xl5:
    buffer_load_dwordx4 v[108:111], v1, s[12:15], s30 offen nt
    buffer_load_dwordx4 v[112:115], v1, s[12:15], s30 offen offset:128 nt
    buffer_load_dwordx4 v[116:119], v1, s[12:15], s30 offen offset:256 nt
    s_add_u32 s30, s30, 12288
    s_cmp_ge_u32 s30, s34
    s_cselect_b32 s35, 1572864, 0
    s_sub_u32 s30, s30, s35
    v_add_f32 v15, v10, v11
    s_nop 1
    v_add_f32_dpp v15, v15, v15 quad_perm:[1,0,3,2] row_mask:0xf bank_mask:0xf
    s_nop 1
    v_add_f32_dpp v15, v15, v15 quad_perm:[2,3,0,1] row_mask:0xf bank_mask:0xf
    s_nop 1
    v_add_f32_dpp v15, v15, v15 row_half_mirror row_mask:0xf bank_mask:0xf
    v_max_f32 v3, v3, v15
    s_waitcnt vmcnt(21)
    v_mov_b32 v10, 0
    v_mov_b32 v11, 0
    v_dot2c_f32_bf16 v10, v120, v36
    v_dot2c_f32_bf16 v11, v121, v37
    v_dot2c_f32_bf16 v10, v122, v38
    v_dot2c_f32_bf16 v11, v123, v39
    v_dot2c_f32_bf16 v10, v124, v40
    v_dot2c_f32_bf16 v11, v125, v41
    v_dot2c_f32_bf16 v10, v126, v42
    v_dot2c_f32_bf16 v11, v127, v43
    v_dot2c_f32_bf16 v10, v128, v44
    v_dot2c_f32_bf16 v11, v129, v45
    v_dot2c_f32_bf16 v10, v130, v46
    v_dot2c_f32_bf16 v11, v131, v47
    s_cmp_eq_u32 s37, 0
    s_cbranch_scc1 L_xl6
    s_waitcnt vmcnt(5)
L_xl6:
    buffer_load_dwordx4 v[120:123], v1, s[12:15], s30 offen nt
    buffer_load_dwordx4 v[124:127], v1, s[12:15], s30 offen offset:128 nt
    buffer_load_dwordx4 v[128:131], v1, s[12:15], s30 offen offset:256 nt
    s_add_u32 s30, s30, 12288
    s_cmp_ge_u32 s30, s34
    s_cselect_b32 s35, 1572864, 0
    s_sub_u32 s30, s30, s35
    v_add_f32 v16, v8, v9
    s_nop 1
    v_add_f32_dpp v16, v16, v16 quad_perm:[1,0,3,2] row_mask:0xf bank_mask:0xf
    s_nop 1
    v_add_f32_dpp v16, v16, v16 quad_perm:[2,3,0,1] row_mask:0xf bank_mask:0xf
    s_nop 1
    v_add_f32_dpp v16, v16, v16 row_half_mirror row_mask:0xf bank_mask:0xf
    v_max_f32 v3, v3, v16
    s_waitcnt vmcnt(21)
    v_mov_b32 v8, 0
    v_mov_b32 v9, 0
    v_dot2c_f32_bf16 v8, v132, v36
    v_dot2c_f32_bf16 v9, v133, v37
    v_dot2c_f32_bf16 v8, v134, v38
    v_dot2c_f32_bf16 v9, v135, v39
    v_dot2c_f32_bf16 v8, v136, v40
    v_dot2c_f32_bf16 v9, v137, v41
    v_dot2c_f32_bf16 v8, v138, v42
    v_dot2c_f32_bf16 v9, v139, v43
    v_dot2c_f32_bf16 v8, v140, v44
    v_dot2c_f32_bf16 v9, v141, v45
    v_dot2c_f32_bf16 v8, v142, v46
    v_dot2c_f32_bf16 v9, v143, v47
    s_cmp_eq_u32 s37, 0
    s_cbranch_scc1 L_xl7
    s_waitcnt vmcnt(5)
L_xl7:
    buffer_load_dwordx4 v[132:135], v1, s[12:15], s30 offen nt
    buffer_load_dwordx4 v[136:139], v1, s[12:15], s30 offen offset:128 nt
    buffer_load_dwordx4 v[140:143], v1, s[12:15], s30 offen offset:256 nt
    s_add_u32 s30, s30, 12288
    s_cmp_ge_u32 s30, s34
    s_cselect_b32 s35, 1572864, 0
    s_sub_u32 s30, s30, s35
    v_add_f32 v17, v10, v11
    s_nop 1
    v_add_f32_dpp v17, v17, v17 quad_perm:[1,0,3,2] row_mask:0xf bank_mask:0xf
    s_nop 1
    v_add_f32_dpp v17, v17, v17 quad_perm:[2,3,0,1] row_mask:0xf bank_mask:0xf
    s_nop 1
    v_add_f32_dpp v17, v17, v17 row_half_mirror row_mask:0xf bank_mask:0xf
    v_max_f32 v3, v3, v17
    s_waitcnt vmcnt(21)
    v_mov_b32 v10, 0
    v_mov_b32 v11, 0
    v_dot2c_f32_bf16 v10, v144, v36
    v_dot2c_f32_bf16 v11, v145, v37
    v_dot2c_f32_bf16 v10, v146, v38
    v_dot2c_f32_bf16 v11, v147, v39
    v_dot2c_f32_bf16 v10, v148, v40
    v_dot2c_f32_bf16 v11, v149, v41
    v_dot2c_f32_bf16 v10, v150, v42
    v_dot2c_f32_bf16 v11, v151, v43
    v_dot2c_f32_bf16 v10, v152, v44
    v_dot2c_f32_bf16 v11, v153, v45
    v_dot2c_f32_bf16 v10, v154, v46
    v_dot2c_f32_bf16 v11, v155, v47
    s_cmp_eq_u32 s37, 0
    s_cbranch_scc1 L_xl8
    s_waitcnt vmcnt(5)
L_xl8:
    buffer_load_dwordx4 v[144:147], v1, s[12:15], s30 offen nt
    buffer_load_dwordx4 v[148:151], v1, s[12:15], s30 offen offset:128 nt
    buffer_load_dwordx4 v[152:155], v1, s[12:15], s30 offen offset:256 nt
    s_add_u32 s30, s30, 12288
    s_cmp_ge_u32 s30, s34
    s_cselect_b32 s35, 1572864, 0
    s_sub_u32 s30, s30, s35
    v_add_f32 v18, v8, v9
    s_nop 1
    v_add_f32_dpp v18, v18, v18 quad_perm:[1,0,3,2] row_mask:0xf bank_mask:0xf
    s_nop 1
    v_add_f32_dpp v18, v18, v18 quad_perm:[2,3,0,1] row_mask:0xf bank_mask:0xf
    s_nop 1
    v_add_f32_dpp v18, v18, v18 row_half_mirror row_mask:0xf bank_mask:0xf
    v_max_f32 v3, v3, v18
    v_add_f32 v19, v10, v11
    s_nop 1
    v_add_f32_dpp v19, v19, v19 quad_perm:[1,0,3,2] row_mask:0xf bank_mask:0xf
    s_nop 1
    v_add_f32_dpp v19, v19, v19 quad_perm:[2,3,0,1] row_mask:0xf bank_mask:0xf
    s_nop 1
    v_add_f32_dpp v19, v19, v19 row_half_mirror row_mask:0xf bank_mask:0xf
    v_max_f32 v3, v3, v19
    ds_write_b128 v2, v[12:15]
    ds_write_b128 v2, v[16:19] offset:16
    s_nop 1
    v_add_u32 v2, 32, v2
    s_sub_u32 s29, s29, 1
    s_cmp_lg_u32 s29, 0
    s_nop 0
    s_cbranch_scc1 L_k
    s_mul_i32 s30, s28, 3072
    s_mov_b32 s30, s36
    s_add_u32 s30, s30, s28
    s_and_b32 s30, s30, 511
    s_mul_i32 s30, s30, 3072
    s_waitcnt vmcnt(21)
    v_mov_b32 v8, 0
    v_mov_b32 v9, 0
    v_dot2c_f32_bf16 v8, v60, v36
    v_dot2c_f32_bf16 v9, v61, v37
    v_dot2c_f32_bf16 v8, v62, v38
    v_dot2c_f32_bf16 v9, v63, v39
    v_dot2c_f32_bf16 v8, v64, v40
    v_dot2c_f32_bf16 v9, v65, v41
    v_dot2c_f32_bf16 v8, v66, v42
    v_dot2c_f32_bf16 v9, v67, v43
    v_dot2c_f32_bf16 v8, v68, v44
    v_dot2c_f32_bf16 v9, v69, v45
    v_dot2c_f32_bf16 v8, v70, v46
    v_dot2c_f32_bf16 v9, v71, v47
    s_cmp_eq_u32 s37, 0
    s_cbranch_scc1 L_xl9
    s_waitcnt vmcnt(5)
L_xl9:
    buffer_load_dwordx4 v[60:63], v1, s[16:19], s30 offen nt
    buffer_load_dwordx4 v[64:67], v1, s[16:19], s30 offen offset:128 nt
    buffer_load_dwordx4 v[68:71], v1, s[16:19], s30 offen offset:256 nt
    s_add_u32 s30, s30, 12288
    s_cmp_ge_u32 s30, s34
    s_cselect_b32 s35, 1572864, 0
    s_sub_u32 s30, s30, s35
    s_waitcnt vmcnt(21)
    v_mov_b32 v10, 0
    v_mov_b32 v11, 0
    v_dot2c_f32_bf16 v10, v72, v36
    v_dot2c_f32_bf16 v11, v73, v37
    v_dot2c_f32_bf16 v10, v74, v38
    v_dot2c_f32_bf16 v11, v75, v39
    v_dot2c_f32_bf16 v10, v76, v40
    v_dot2c_f32_bf16 v11, v77, v41
    v_dot2c_f32_bf16 v10, v78, v42
    v_dot2c_f32_bf16 v11, v79, v43
    v_dot2c_f32_bf16 v10, v80, v44
    v_dot2c_f32_bf16 v11, v81, v45
    v_dot2c_f32_bf16 v10, v82, v46
    v_dot2c_f32_bf16 v11, v83, v47
    s_cmp_eq_u32 s37, 0
    s_cbranch_scc1 L_xl10
    s_waitcnt vmcnt(5)
L_xl10:
    buffer_load_dwordx4 v[72:75], v1, s[16:19], s30 offen nt
    buffer_load_dwordx4 v[76:79], v1, s[16:19], s30 offen offset:128 nt
    buffer_load_dwordx4 v[80:83], v1, s[16:19], s30 offen offset:256 nt
    s_add_u32 s30, s30, 12288
    s_cmp_ge_u32 s30, s34
    s_cselect_b32 s35, 1572864, 0
    s_sub_u32 s30, s30, s35
    v_add_f32 v12, v8, v9
    s_nop 1
    v_add_f32_dpp v12, v12, v12 quad_perm:[1,0,3,2] row_mask:0xf bank_mask:0xf
    s_nop 1
    v_add_f32_dpp v12, v12, v12 quad_perm:[2,3,0,1] row_mask:0xf bank_mask:0xf
    s_nop 1
    v_add_f32_dpp v12, v12, v12 row_half_mirror row_mask:0xf bank_mask:0xf
    v_max_f32 v3, v3, v12
    s_waitcnt vmcnt(21)
    v_mov_b32 v8, 0
    v_mov_b32 v9, 0
    v_dot2c_f32_bf16 v8, v84, v36
    v_dot2c_f32_bf16 v9, v85, v37
    v_dot2c_f32_bf16 v8, v86, v38
    v_dot2c_f32_bf16 v9, v87, v39
    v_dot2c_f32_bf16 v8, v88, v40
    v_dot2c_f32_bf16 v9, v89, v41
    v_dot2c_f32_bf16 v8, v90, v42
    v_dot2c_f32_bf16 v9, v91, v43
    v_dot2c_f32_bf16 v8, v92, v44
    v_dot2c_f32_bf16 v9, v93, v45
    v_dot2c_f32_bf16 v8, v94, v46
    v_dot2c_f32_bf16 v9, v95, v47
    s_cmp_eq_u32 s37, 0
    s_cbranch_scc1 L_xl11
    s_waitcnt vmcnt(5)
L_xl11:
    buffer_load_dwordx4 v[84:87], v1, s[16:19], s30 offen nt
    buffer_load_dwordx4 v[88:91], v1, s[16:19], s30 offen offset:128 nt
    buffer_load_dwordx4 v[92:95], v1, s[16:19], s30 offen offset:256 nt
    s_add_u32 s30, s30, 12288
    s_cmp_ge_u32 s30, s34
    s_cselect_b32 s35, 1572864, 0
    s_sub_u32 s30, s30, s35
    v_add_f32 v13, v10, v11
    s_nop 1
    v_add_f32_dpp v13, v13, v13 quad_perm:[1,0,3,2] row_mask:0xf bank_mask:0xf
    s_nop 1
    v_add_f32_dpp v13, v13, v13 quad_perm:[2,3,0,1] row_mask:0xf bank_mask:0xf
    s_nop 1
    v_add_f32_dpp v13, v13, v13 row_half_mirror row_mask:0xf bank_mask:0xf
    v_max_f32 v3, v3, v13
    s_waitcnt vmcnt(21)
    v_mov_b32 v10, 0
    v_mov_b32 v11, 0
    v_dot2c_f32_bf16 v10, v96, v36
    v_dot2c_f32_bf16 v11, v97, v37
    v_dot2c_f32_bf16 v10, v98, v38
    v_dot2c_f32_bf16 v11, v99, v39
    v_dot2c_f32_bf16 v10, v100, v40
    v_dot2c_f32_bf16 v11, v101, v41
    v_dot2c_f32_bf16 v10, v102, v42
    v_dot2c_f32_bf16 v11, v103, v43
    v_dot2c_f32_bf16 v10, v104, v44
    v_dot2c_f32_bf16 v11, v105, v45
    v_dot2c_f32_bf16 v10, v106, v46
    v_dot2c_f32_bf16 v11, v107, v47
    s_cmp_eq_u32 s37, 0
    s_cbranch_scc1 L_xl12
    s_waitcnt vmcnt(5)
L_xl12:
    buffer_load_dwordx4 v[96:99], v1, s[16:19], s30 offen nt
    buffer_load_dwordx4 v[100:103], v1, s[16:19], s30 offen offset:128 nt
    buffer_load_dwordx4 v[104:107], v1, s[16:19], s30 offen offset:256 nt
    s_add_u32 s30, s30, 12288
    s_cmp_ge_u32 s30, s34
    s_cselect_b32 s35, 1572864, 0
    s_sub_u32 s30, s30, s35
    v_add_f32 v14, v8, v9
    s_nop 1
    v_add_f32_dpp v14, v14, v14 quad_perm:[1,0,3,2] row_mask:0xf bank_mask:0xf
    s_nop 1
    v_add_f32_dpp v14, v14, v14 quad_perm:[2,3,0,1] row_mask:0xf bank_mask:0xf
    s_nop 1
    v_add_f32_dpp v14, v14, v14 row_half_mirror row_mask:0xf bank_mask:0xf
    v_max_f32 v3, v3, v14
    s_waitcnt vmcnt(21)
    v_mov_b32 v8, 0
    v_mov_b32 v9, 0
    v_dot2c_f32_bf16 v8, v108, v36
    v_dot2c_f32_bf16 v9, v109, v37
    v_dot2c_f32_bf16 v8, v110, v38
    v_dot2c_f32_bf16 v9, v111, v39
    v_dot2c_f32_bf16 v8, v112, v40
    v_dot2c_f32_bf16 v9, v113, v41
    v_dot2c_f32_bf16 v8, v114, v42
    v_dot2c_f32_bf16 v9, v115, v43
    v_dot2c_f32_bf16 v8, v116, v44
    v_dot2c_f32_bf16 v9, v117, v45
    v_dot2c_f32_bf16 v8, v118, v46
    v_dot2c_f32_bf16 v9, v119, v47
    s_cmp_eq_u32 s37, 0
    s_cbranch_scc1 L_xl13
    s_waitcnt vmcnt(5)
L_xl13:
    buffer_load_dwordx4 v[108:111], v1, s[16:19], s30 offen nt
    buffer_load_dwordx4 v[112:115], v1, s[16:19], s30 offen offset:128 nt
    buffer_load_dwordx4 v[116:119], v1, s[16:19], s30 offen offset:256 nt
    s_add_u32 s30, s30, 12288
    s_cmp_ge_u32 s30, s34
    s_cselect_b32 s35, 1572864, 0
    s_sub_u32 s30, s30, s35
    v_add_f32 v15, v10, v11
    s_nop 1
    v_add_f32_dpp v15, v15, v15 quad_perm:[1,0,3,2] row_mask:0xf bank_mask:0xf
    s_nop 1
    v_add_f32_dpp v15, v15, v15 quad_perm:[2,3,0,1] row_mask:0xf bank_mask:0xf
    s_nop 1
    v_add_f32_dpp v15, v15, v15 row_half_mirror row_mask:0xf bank_mask:0xf
    v_max_f32 v3, v3, v15
    s_waitcnt vmcnt(21)
    v_mov_b32 v10, 0
    v_mov_b32 v11, 0
    v_dot2c_f32_bf16 v10, v120, v36
    v_dot2c_f32_bf16 v11, v121, v37
    v_dot2c_f32_bf16 v10, v122, v38
    v_dot2c_f32_bf16 v11, v123, v39
    v_dot2c_f32_bf16 v10, v124, v40
    v_dot2c_f32_bf16 v11, v125, v41
    v_dot2c_f32_bf16 v10, v126, v42
    v_dot2c_f32_bf16 v11, v127, v43
    v_dot2c_f32_bf16 v10, v128, v44
    v_dot2c_f32_bf16 v11, v129, v45
    v_dot2c_f32_bf16 v10, v130, v46
    v_dot2c_f32_bf16 v11, v131, v47
    s_cmp_eq_u32 s37, 0
    s_cbranch_scc1 L_xl14
    s_waitcnt vmcnt(5)
L_xl14:
    buffer_load_dwordx4 v[120:123], v1, s[16:19], s30 offen nt
    buffer_load_dwordx4 v[124:127], v1, s[16:19], s30 offen offset:128 nt
    buffer_load_dwordx4 v[128:131], v1, s[16:19], s30 offen offset:256 nt
    s_add_u32 s30, s30, 12288
    s_cmp_ge_u32 s30, s34
    s_cselect_b32 s35, 1572864, 0
    s_sub_u32 s30, s30, s35
    v_add_f32 v16, v8, v9
    s_nop 1
    v_add_f32_dpp v16, v16, v16 quad_perm:[1,0,3,2] row_mask:0xf bank_mask:0xf
    s_nop 1
    v_add_f32_dpp v16, v16, v16 quad_perm:[2,3,0,1] row_mask:0xf bank_mask:0xf
    s_nop 1
    v_add_f32_dpp v16, v16, v16 row_half_mirror row_mask:0xf bank_mask:0xf
    v_max_f32 v3, v3, v16
    s_waitcnt vmcnt(21)
    v_mov_b32 v8, 0
    v_mov_b32 v9, 0
    v_dot2c_f32_bf16 v8, v132, v36
    v_dot2c_f32_bf16 v9, v133, v37
    v_dot2c_f32_bf16 v8, v134, v38
    v_dot2c_f32_bf16 v9, v135, v39
    v_dot2c_f32_bf16 v8, v136, v40
    v_dot2c_f32_bf16 v9, v137, v41
    v_dot2c_f32_bf16 v8, v138, v42
    v_dot2c_f32_bf16 v9, v139, v43
    v_dot2c_f32_bf16 v8, v140, v44
    v_dot2c_f32_bf16 v9, v141, v45
    v_dot2c_f32_bf16 v8, v142, v46
    v_dot2c_f32_bf16 v9, v143, v47
    s_cmp_eq_u32 s37, 0
    s_cbranch_scc1 L_xl15
    s_waitcnt vmcnt(5)
L_xl15:
    buffer_load_dwordx4 v[132:135], v1, s[16:19], s30 offen nt
    buffer_load_dwordx4 v[136:139], v1, s[16:19], s30 offen offset:128 nt
    buffer_load_dwordx4 v[140:143], v1, s[16:19], s30 offen offset:256 nt
    s_add_u32 s30, s30, 12288
    s_cmp_ge_u32 s30, s34
    s_cselect_b32 s35, 1572864, 0
    s_sub_u32 s30, s30, s35
    v_add_f32 v17, v10, v11
    s_nop 1
    v_add_f32_dpp v17, v17, v17 quad_perm:[1,0,3,2] row_mask:0xf bank_mask:0xf
    s_nop 1
    v_add_f32_dpp v17, v17, v17 quad_perm:[2,3,0,1] row_mask:0xf bank_mask:0xf
    s_nop 1
    v_add_f32_dpp v17, v17, v17 row_half_mirror row_mask:0xf bank_mask:0xf
    v_max_f32 v3, v3, v17
    s_waitcnt vmcnt(21)
    v_mov_b32 v10, 0
    v_mov_b32 v11, 0
    v_dot2c_f32_bf16 v10, v144, v36
    v_dot2c_f32_bf16 v11, v145, v37
    v_dot2c_f32_bf16 v10, v146, v38
    v_dot2c_f32_bf16 v11, v147, v39
    v_dot2c_f32_bf16 v10, v148, v40
    v_dot2c_f32_bf16 v11, v149, v41
    v_dot2c_f32_bf16 v10, v150, v42
    v_dot2c_f32_bf16 v11, v151, v43
    v_dot2c_f32_bf16 v10, v152, v44
    v_dot2c_f32_bf16 v11, v153, v45
    v_dot2c_f32_bf16 v10, v154, v46
    v_dot2c_f32_bf16 v11, v155, v47
    s_cmp_eq_u32 s37, 0
    s_cbranch_scc1 L_xl16
    s_waitcnt vmcnt(5)
L_xl16:
    buffer_load_dwordx4 v[144:147], v1, s[16:19], s30 offen nt
    buffer_load_dwordx4 v[148:151], v1, s[16:19], s30 offen offset:128 nt
    buffer_load_dwordx4 v[152:155], v1, s[16:19], s30 offen offset:256 nt
    s_add_u32 s30, s30, 12288
    s_cmp_ge_u32 s30, s34
    s_cselect_b32 s35, 1572864, 0
    s_sub_u32 s30, s30, s35
    v_add_f32 v18, v8, v9
    s_nop 1
    v_add_f32_dpp v18, v18, v18 quad_perm:[1,0,3,2] row_mask:0xf bank_mask:0xf
    s_nop 1
    v_add_f32_dpp v18, v18, v18 quad_perm:[2,3,0,1] row_mask:0xf bank_mask:0xf
    s_nop 1
    v_add_f32_dpp v18, v18, v18 row_half_mirror row_mask:0xf bank_mask:0xf
    v_max_f32 v3, v3, v18
    v_add_f32 v19, v10, v11
    s_nop 1
    v_add_f32_dpp v19, v19, v19 quad_perm:[1,0,3,2] row_mask:0xf bank_mask:0xf
    s_nop 1
    v_add_f32_dpp v19, v19, v19 quad_perm:[2,3,0,1] row_mask:0xf bank_mask:0xf
    s_nop 1
    v_add_f32_dpp v19, v19, v19 row_half_mirror row_mask:0xf bank_mask:0xf
    v_max_f32 v3, v3, v19
    ds_write_b128 v2, v[12:15]
    ds_write_b128 v2, v[16:19] offset:16
    s_nop 1
    v_add_u32 v2, 32, v2
    v_max_f32_dpp v3, v3, v3 row_ror:8 row_mask:0xf bank_mask:0xf
    v_mov_b32 v5, v3
    s_nop 1
    v_permlane16_swap_b32 v3, v5
    v_max_f32 v3, v3, v5
    v_mov_b32 v5, v3
    s_nop 1
    v_permlane32_swap_b32 v3, v5
    v_max_f32 v3, v3, v5
    v_mul_f32 v3, s31, v3
    v_subrev_u32 v2, 512, v2
    v_mov_b32 v36, 0
    v_mov_b32 v37, 0
    v_mov_b32 v38, 0
    v_mov_b32 v39, 0
    v_mov_b32 v40, 0
    v_mov_b32 v41, 0
    v_mov_b32 v42, 0
    v_mov_b32 v43, 0
    v_mov_b32 v44, 0
    v_mov_b32 v45, 0
    v_mov_b32 v46, 0
    v_mov_b32 v47, 0
    v_mov_b32 v48, 0
    v_mov_b32 v49, 0
    v_mov_b32 v50, 0
    v_mov_b32 v51, 0
    v_mov_b32 v52, 0
    v_mov_b32 v53, 0
    v_mov_b32 v54, 0
    v_mov_b32 v55, 0
    v_mov_b32 v56, 0
    v_mov_b32 v57, 0
    v_mov_b32 v58, 0
    v_mov_b32 v59, 0
    s_waitcnt lgkmcnt(0)
    ds_read_b128 v[12:15], v2
    ds_read_b128 v[16:19], v2 offset:16
    v_add_u32 v2, 32, v2
    s_mov_b32 s29, 15
    s_nop 1
L_v:
    s_waitcnt lgkmcnt(0)
    v_fma_f32 v12, v12, s31, -v3
    v_fma_f32 v13, v13, s31, -v3
    v_fma_f32 v14, v14, s31, -v3
    v_fma_f32 v15, v15, s31, -v3
    v_fma_f32 v16, v16, s31, -v3
    v_fma_f32 v17, v17, s31, -v3
    v_fma_f32 v18, v18, s31, -v3
    v_fma_f32 v19, v19, s31, -v3
    v_exp_f32 v12, v12
    v_exp_f32 v13, v13
    v_exp_f32 v14, v14
    v_exp_f32 v15, v15
    v_exp_f32 v16, v16
    v_exp_f32 v17, v17
    v_exp_f32 v18, v18
    v_exp_f32 v19, v19
    v_cvt_pk_bf16_f32 v20, v12, 0
    v_cvt_pk_bf16_f32 v28, 0, v12
    v_cvt_pk_bf16_f32 v21, v13, 0
    v_cvt_pk_bf16_f32 v29, 0, v13
    v_cvt_pk_bf16_f32 v22, v14, 0
    v_cvt_pk_bf16_f32 v30, 0, v14
    v_cvt_pk_bf16_f32 v23, v15, 0
    v_cvt_pk_bf16_f32 v31, 0, v15
    v_cvt_pk_bf16_f32 v24, v16, 0
    v_cvt_pk_bf16_f32 v32, 0, v16
    v_cvt_pk_bf16_f32 v25, v17, 0
    v_cvt_pk_bf16_f32 v33, 0, v17
    v_cvt_pk_bf16_f32 v26, v18, 0
    v_cvt_pk_bf16_f32 v34, 0, v18
    v_cvt_pk_bf16_f32 v27, v19, 0
    v_cvt_pk_bf16_f32 v35, 0, v19
    v_add_f32 v4, v4, v28
    v_add_f32 v4, v4, v29
    v_add_f32 v4, v4, v30
    v_add_f32 v4, v4, v31
    v_add_f32 v4, v4, v32
    v_add_f32 v4, v4, v33
    v_add_f32 v4, v4, v34
    v_add_f32 v4, v4, v35
    ds_read_b128 v[12:15], v2
    ds_read_b128 v[16:19], v2 offset:16
    v_add_u32 v2, 32, v2
    s_waitcnt vmcnt(21)
    v_dot2c_f32_bf16 v36, v60, v20
    v_dot2c_f32_bf16 v37, v60, v28
    v_dot2c_f32_bf16 v38, v61, v20
    v_dot2c_f32_bf16 v39, v61, v28
    v_dot2c_f32_bf16 v40, v62, v20
    v_dot2c_f32_bf16 v41, v62, v28
    v_dot2c_f32_bf16 v42, v63, v20
    v_dot2c_f32_bf16 v43, v63, v28
    v_dot2c_f32_bf16 v44, v64, v20
    v_dot2c_f32_bf16 v45, v64, v28
    v_dot2c_f32_bf16 v46, v65, v20
    v_dot2c_f32_bf16 v47, v65, v28
    v_dot2c_f32_bf16 v48, v66, v20
    v_dot2c_f32_bf16 v49, v66, v28
    v_dot2c_f32_bf16 v50, v67, v20
    v_dot2c_f32_bf16 v51, v67, v28
    v_dot2c_f32_bf16 v52, v68, v20
    v_dot2c_f32_bf16 v53, v68, v28
    v_dot2c_f32_bf16 v54, v69, v20
    v_dot2c_f32_bf16 v55, v69, v28
    v_dot2c_f32_bf16 v56, v70, v20
    v_dot2c_f32_bf16 v57, v70, v28
    v_dot2c_f32_bf16 v58, v71, v20
    v_dot2c_f32_bf16 v59, v71, v28
    s_cmp_eq_u32 s37, 0
    s_cbranch_scc1 L_xl17
    s_waitcnt vmcnt(5)
L_xl17:
    buffer_load_dwordx4 v[60:63], v1, s[16:19], s30 offen nt
    buffer_load_dwordx4 v[64:67], v1, s[16:19], s30 offen offset:128 nt
    buffer_load_dwordx4 v[68:71], v1, s[16:19], s30 offen offset:256 nt
    s_add_u32 s30, s30, 12288
    s_cmp_ge_u32 s30, s34
    s_cselect_b32 s35, 1572864, 0
    s_sub_u32 s30, s30, s35
    s_waitcnt vmcnt(21)
    v_dot2c_f32_bf16 v36, v72, v21
    v_dot2c_f32_bf16 v37, v72, v29
    v_dot2c_f32_bf16 v38, v73, v21
    v_dot2c_f32_bf16 v39, v73, v29
    v_dot2c_f32_bf16 v40, v74, v21
    v_dot2c_f32_bf16 v41, v74, v29
    v_dot2c_f32_bf16 v42, v75, v21
    v_dot2c_f32_bf16 v43, v75, v29
    v_dot2c_f32_bf16 v44, v76, v21
    v_dot2c_f32_bf16 v45, v76, v29
    v_dot2c_f32_bf16 v46, v77, v21
    v_dot2c_f32_bf16 v47, v77, v29
    v_dot2c_f32_bf16 v48, v78, v21
    v_dot2c_f32_bf16 v49, v78, v29
    v_dot2c_f32_bf16 v50, v79, v21
    v_dot2c_f32_bf16 v51, v79, v29
    v_dot2c_f32_bf16 v52, v80, v21
    v_dot2c_f32_bf16 v53, v80, v29
    v_dot2c_f32_bf16 v54, v81, v21
    v_dot2c_f32_bf16 v55, v81, v29
    v_dot2c_f32_bf16 v56, v82, v21
    v_dot2c_f32_bf16 v57, v82, v29
    v_dot2c_f32_bf16 v58, v83, v21
    v_dot2c_f32_bf16 v59, v83, v29
    s_cmp_eq_u32 s37, 0
    s_cbranch_scc1 L_xl18
    s_waitcnt vmcnt(5)
L_xl18:
    buffer_load_dwordx4 v[72:75], v1, s[16:19], s30 offen nt
    buffer_load_dwordx4 v[76:79], v1, s[16:19], s30 offen offset:128 nt
    buffer_load_dwordx4 v[80:83], v1, s[16:19], s30 offen offset:256 nt
    s_add_u32 s30, s30, 12288
    s_cmp_ge_u32 s30, s34
    s_cselect_b32 s35, 1572864, 0
    s_sub_u32 s30, s30, s35
    s_waitcnt vmcnt(21)
    v_dot2c_f32_bf16 v36, v84, v22
    v_dot2c_f32_bf16 v37, v84, v30
    v_dot2c_f32_bf16 v38, v85, v22
    v_dot2c_f32_bf16 v39, v85, v30
    v_dot2c_f32_bf16 v40, v86, v22
    v_dot2c_f32_bf16 v41, v86, v30
    v_dot2c_f32_bf16 v42, v87, v22
    v_dot2c_f32_bf16 v43, v87, v30
    v_dot2c_f32_bf16 v44, v88, v22
    v_dot2c_f32_bf16 v45, v88, v30
    v_dot2c_f32_bf16 v46, v89, v22
    v_dot2c_f32_bf16 v47, v89, v30
    v_dot2c_f32_bf16 v48, v90, v22
    v_dot2c_f32_bf16 v49, v90, v30
    v_dot2c_f32_bf16 v50, v91, v22
    v_dot2c_f32_bf16 v51, v91, v30
    v_dot2c_f32_bf16 v52, v92, v22
    v_dot2c_f32_bf16 v53, v92, v30
    v_dot2c_f32_bf16 v54, v93, v22
    v_dot2c_f32_bf16 v55, v93, v30
    v_dot2c_f32_bf16 v56, v94, v22
    v_dot2c_f32_bf16 v57, v94, v30
    v_dot2c_f32_bf16 v58, v95, v22
    v_dot2c_f32_bf16 v59, v95, v30
    s_cmp_eq_u32 s37, 0
    s_cbranch_scc1 L_xl19
    s_waitcnt vmcnt(5)
L_xl19:
    buffer_load_dwordx4 v[84:87], v1, s[16:19], s30 offen nt
    buffer_load_dwordx4 v[88:91], v1, s[16:19], s30 offen offset:128 nt
    buffer_load_dwordx4 v[92:95], v1, s[16:19], s30 offen offset:256 nt
    s_add_u32 s30, s30, 12288
    s_cmp_ge_u32 s30, s34
    s_cselect_b32 s35, 1572864, 0
    s_sub_u32 s30, s30, s35
    s_waitcnt vmcnt(21)
    v_dot2c_f32_bf16 v36, v96, v23
    v_dot2c_f32_bf16 v37, v96, v31
    v_dot2c_f32_bf16 v38, v97, v23
    v_dot2c_f32_bf16 v39, v97, v31
    v_dot2c_f32_bf16 v40, v98, v23
    v_dot2c_f32_bf16 v41, v98, v31
    v_dot2c_f32_bf16 v42, v99, v23
    v_dot2c_f32_bf16 v43, v99, v31
    v_dot2c_f32_bf16 v44, v100, v23
    v_dot2c_f32_bf16 v45, v100, v31
    v_dot2c_f32_bf16 v46, v101, v23
    v_dot2c_f32_bf16 v47, v101, v31
    v_dot2c_f32_bf16 v48, v102, v23
    v_dot2c_f32_bf16 v49, v102, v31
    v_dot2c_f32_bf16 v50, v103, v23
    v_dot2c_f32_bf16 v51, v103, v31
    v_dot2c_f32_bf16 v52, v104, v23
    v_dot2c_f32_bf16 v53, v104, v31
    v_dot2c_f32_bf16 v54, v105, v23
    v_dot2c_f32_bf16 v55, v105, v31
    v_dot2c_f32_bf16 v56, v106, v23
    v_dot2c_f32_bf16 v57, v106, v31
    v_dot2c_f32_bf16 v58, v107, v23
    v_dot2c_f32_bf16 v59, v107, v31
    s_cmp_eq_u32 s37, 0
    s_cbranch_scc1 L_xl20
    s_waitcnt vmcnt(5)
L_xl20:
    buffer_load_dwordx4 v[96:99], v1, s[16:19], s30 offen nt
    buffer_load_dwordx4 v[100:103], v1, s[16:19], s30 offen offset:128 nt
    buffer_load_dwordx4 v[104:107], v1, s[16:19], s30 offen offset:256 nt
    s_add_u32 s30, s30, 12288
    s_cmp_ge_u32 s30, s34
    s_cselect_b32 s35, 1572864, 0
    s_sub_u32 s30, s30, s35
    s_waitcnt vmcnt(21)
    v_dot2c_f32_bf16 v36, v108, v24
    v_dot2c_f32_bf16 v37, v108, v32
    v_dot2c_f32_bf16 v38, v109, v24
    v_dot2c_f32_bf16 v39, v109, v32
    v_dot2c_f32_bf16 v40, v110, v24
    v_dot2c_f32_bf16 v41, v110, v32
    v_dot2c_f32_bf16 v42, v111, v24
    v_dot2c_f32_bf16 v43, v111, v32
    v_dot2c_f32_bf16 v44, v112, v24
    v_dot2c_f32_bf16 v45, v112, v32
    v_dot2c_f32_bf16 v46, v113, v24
    v_dot2c_f32_bf16 v47, v113, v32
    v_dot2c_f32_bf16 v48, v114, v24
    v_dot2c_f32_bf16 v49, v114, v32
    v_dot2c_f32_bf16 v50, v115, v24
    v_dot2c_f32_bf16 v51, v115, v32
    v_dot2c_f32_bf16 v52, v116, v24
    v_dot2c_f32_bf16 v53, v116, v32
    v_dot2c_f32_bf16 v54, v117, v24
    v_dot2c_f32_bf16 v55, v117, v32
    v_dot2c_f32_bf16 v56, v118, v24
    v_dot2c_f32_bf16 v57, v118, v32
    v_dot2c_f32_bf16 v58, v119, v24
    v_dot2c_f32_bf16 v59, v119, v32
    s_cmp_eq_u32 s37, 0
    s_cbranch_scc1 L_xl21
    s_waitcnt vmcnt(5)
L_xl21:
    buffer_load_dwordx4 v[108:111], v1, s[16:19], s30 offen nt
    buffer_load_dwordx4 v[112:115], v1, s[16:19], s30 offen offset:128 nt
    buffer_load_dwordx4 v[116:119], v1, s[16:19], s30 offen offset:256 nt
    s_add_u32 s30, s30, 12288
    s_cmp_ge_u32 s30, s34
    s_cselect_b32 s35, 1572864, 0
    s_sub_u32 s30, s30, s35
    s_waitcnt vmcnt(21)
    v_dot2c_f32_bf16 v36, v120, v25
    v_dot2c_f32_bf16 v37, v120, v33
    v_dot2c_f32_bf16 v38, v121, v25
    v_dot2c_f32_bf16 v39, v121, v33
    v_dot2c_f32_bf16 v40, v122, v25
    v_dot2c_f32_bf16 v41, v122, v33
    v_dot2c_f32_bf16 v42, v123, v25
    v_dot2c_f32_bf16 v43, v123, v33
    v_dot2c_f32_bf16 v44, v124, v25
    v_dot2c_f32_bf16 v45, v124, v33
    v_dot2c_f32_bf16 v46, v125, v25
    v_dot2c_f32_bf16 v47, v125, v33
    v_dot2c_f32_bf16 v48, v126, v25
    v_dot2c_f32_bf16 v49, v126, v33
    v_dot2c_f32_bf16 v50, v127, v25
    v_dot2c_f32_bf16 v51, v127, v33
    v_dot2c_f32_bf16 v52, v128, v25
    v_dot2c_f32_bf16 v53, v128, v33
    v_dot2c_f32_bf16 v54, v129, v25
    v_dot2c_f32_bf16 v55, v129, v33
    v_dot2c_f32_bf16 v56, v130, v25
    v_dot2c_f32_bf16 v57, v130, v33
    v_dot2c_f32_bf16 v58, v131, v25
    v_dot2c_f32_bf16 v59, v131, v33
    s_cmp_eq_u32 s37, 0
    s_cbranch_scc1 L_xl22
    s_waitcnt vmcnt(5)
L_xl22:
    buffer_load_dwordx4 v[120:123], v1, s[16:19], s30 offen nt
    buffer_load_dwordx4 v[124:127], v1, s[16:19], s30 offen offset:128 nt
    buffer_load_dwordx4 v[128:131], v1, s[16:19], s30 offen offset:256 nt
    s_add_u32 s30, s30, 12288
    s_cmp_ge_u32 s30, s34
    s_cselect_b32 s35, 1572864, 0
    s_sub_u32 s30, s30, s35
    s_waitcnt vmcnt(21)
    v_dot2c_f32_bf16 v36, v132, v26
    v_dot2c_f32_bf16 v37, v132, v34
    v_dot2c_f32_bf16 v38, v133, v26
    v_dot2c_f32_bf16 v39, v133, v34
    v_dot2c_f32_bf16 v40, v134, v26
    v_dot2c_f32_bf16 v41, v134, v34
    v_dot2c_f32_bf16 v42, v135, v26
    v_dot2c_f32_bf16 v43, v135, v34
    v_dot2c_f32_bf16 v44, v136, v26
    v_dot2c_f32_bf16 v45, v136, v34
    v_dot2c_f32_bf16 v46, v137, v26
    v_dot2c_f32_bf16 v47, v137, v34
    v_dot2c_f32_bf16 v48, v138, v26
    v_dot2c_f32_bf16 v49, v138, v34
    v_dot2c_f32_bf16 v50, v139, v26
    v_dot2c_f32_bf16 v51, v139, v34
    v_dot2c_f32_bf16 v52, v140, v26
    v_dot2c_f32_bf16 v53, v140, v34
    v_dot2c_f32_bf16 v54, v141, v26
    v_dot2c_f32_bf16 v55, v141, v34
    v_dot2c_f32_bf16 v56, v142, v26
    v_dot2c_f32_bf16 v57, v142, v34
    v_dot2c_f32_bf16 v58, v143, v26
    v_dot2c_f32_bf16 v59, v143, v34
    s_cmp_eq_u32 s37, 0
    s_cbranch_scc1 L_xl23
    s_waitcnt vmcnt(5)
L_xl23:
    buffer_load_dwordx4 v[132:135], v1, s[16:19], s30 offen nt
    buffer_load_dwordx4 v[136:139], v1, s[16:19], s30 offen offset:128 nt
    buffer_load_dwordx4 v[140:143], v1, s[16:19], s30 offen offset:256 nt
    s_add_u32 s30, s30, 12288
    s_cmp_ge_u32 s30, s34
    s_cselect_b32 s35, 1572864, 0
    s_sub_u32 s30, s30, s35
    s_waitcnt vmcnt(21)
    v_dot2c_f32_bf16 v36, v144, v27
    v_dot2c_f32_bf16 v37, v144, v35
    v_dot2c_f32_bf16 v38, v145, v27
    v_dot2c_f32_bf16 v39, v145, v35
    v_dot2c_f32_bf16 v40, v146, v27
    v_dot2c_f32_bf16 v41, v146, v35
    v_dot2c_f32_bf16 v42, v147, v27
    v_dot2c_f32_bf16 v43, v147, v35
    v_dot2c_f32_bf16 v44, v148, v27
    v_dot2c_f32_bf16 v45, v148, v35
    v_dot2c_f32_bf16 v46, v149, v27
    v_dot2c_f32_bf16 v47, v149, v35
    v_dot2c_f32_bf16 v48, v150, v27
    v_dot2c_f32_bf16 v49, v150, v35
    v_dot2c_f32_bf16 v50, v151, v27
    v_dot2c_f32_bf16 v51, v151, v35
    v_dot2c_f32_bf16 v52, v152, v27
    v_dot2c_f32_bf16 v53, v152, v35
    v_dot2c_f32_bf16 v54, v153, v27
    v_dot2c_f32_bf16 v55, v153, v35
    v_dot2c_f32_bf16 v56, v154, v27
    v_dot2c_f32_bf16 v57, v154, v35
    v_dot2c_f32_bf16 v58, v155, v27
    v_dot2c_f32_bf16 v59, v155, v35
    s_cmp_eq_u32 s37, 0
    s_cbranch_scc1 L_xl24
    s_waitcnt vmcnt(5)
L_xl24:
    buffer_load_dwordx4 v[144:147], v1, s[16:19], s30 offen nt
    buffer_load_dwordx4 v[148:151], v1, s[16:19], s30 offen offset:128 nt
    buffer_load_dwordx4 v[152:155], v1, s[16:19], s30 offen offset:256 nt
    s_add_u32 s30, s30, 12288
    s_cmp_ge_u32 s30, s34
    s_cselect_b32 s35, 1572864, 0
    s_sub_u32 s30, s30, s35
    s_sub_u32 s29, s29, 1
    s_cmp_le_u32 s29, 2
    s_cselect_b32 s37, 0, s37
    s_cmp_lg_u32 s29, 0
    s_cbranch_scc1 L_v
    s_waitcnt lgkmcnt(0)
    v_fma_f32 v12, v12, s31, -v3
    v_fma_f32 v13, v13, s31, -v3
    v_fma_f32 v14, v14, s31, -v3
    v_fma_f32 v15, v15, s31, -v3
    v_fma_f32 v16, v16, s31, -v3
    v_fma_f32 v17, v17, s31, -v3
    v_fma_f32 v18, v18, s31, -v3
    v_fma_f32 v19, v19, s31, -v3
    v_exp_f32 v12, v12
    v_exp_f32 v13, v13
    v_exp_f32 v14, v14
    v_exp_f32 v15, v15
    v_exp_f32 v16, v16
    v_exp_f32 v17, v17
    v_exp_f32 v18, v18
    v_exp_f32 v19, v19
    v_cvt_pk_bf16_f32 v20, v12, 0
    v_cvt_pk_bf16_f32 v28, 0, v12
    v_cvt_pk_bf16_f32 v21, v13, 0
    v_cvt_pk_bf16_f32 v29, 0, v13
    v_cvt_pk_bf16_f32 v22, v14, 0
    v_cvt_pk_bf16_f32 v30, 0, v14
    v_cvt_pk_bf16_f32 v23, v15, 0
    v_cvt_pk_bf16_f32 v31, 0, v15
    v_cvt_pk_bf16_f32 v24, v16, 0
    v_cvt_pk_bf16_f32 v32, 0, v16
    v_cvt_pk_bf16_f32 v25, v17, 0
    v_cvt_pk_bf16_f32 v33, 0, v17
    v_cvt_pk_bf16_f32 v26, v18, 0
    v_cvt_pk_bf16_f32 v34, 0, v18
    v_cvt_pk_bf16_f32 v27, v19, 0
    v_cvt_pk_bf16_f32 v35, 0, v19
    v_add_f32 v4, v4, v28
    v_add_f32 v4, v4, v29
    v_add_f32 v4, v4, v30
    v_add_f32 v4, v4, v31
    v_add_f32 v4, v4, v32
    v_add_f32 v4, v4, v33
    v_add_f32 v4, v4, v34
    v_add_f32 v4, v4, v35
    s_waitcnt vmcnt(21)
    v_dot2c_f32_bf16 v36, v60, v20
    v_dot2c_f32_bf16 v37, v60, v28
    v_dot2c_f32_bf16 v38, v61, v20
    v_dot2c_f32_bf16 v39, v61, v28
    v_dot2c_f32_bf16 v40, v62, v20
    v_dot2c_f32_bf16 v41, v62, v28
    v_dot2c_f32_bf16 v42, v63, v20
    v_dot2c_f32_bf16 v43, v63, v28
    v_dot2c_f32_bf16 v44, v64, v20
    v_dot2c_f32_bf16 v45, v64, v28
    v_dot2c_f32_bf16 v46, v65, v20
    v_dot2c_f32_bf16 v47, v65, v28
    v_dot2c_f32_bf16 v48, v66, v20
    v_dot2c_f32_bf16 v49, v66, v28
    v_dot2c_f32_bf16 v50, v67, v20
    v_dot2c_f32_bf16 v51, v67, v28
    v_dot2c_f32_bf16 v52, v68, v20
    v_dot2c_f32_bf16 v53, v68, v28
    v_dot2c_f32_bf16 v54, v69, v20
    v_dot2c_f32_bf16 v55, v69, v28
    v_dot2c_f32_bf16 v56, v70, v20
    v_dot2c_f32_bf16 v57, v70, v28
    v_dot2c_f32_bf16 v58, v71, v20
    v_dot2c_f32_bf16 v59, v71, v28
    s_waitcnt vmcnt(18)
    v_dot2c_f32_bf16 v36, v72, v21
    v_dot2c_f32_bf16 v37, v72, v29
    v_dot2c_f32_bf16 v38, v73, v21
    v_dot2c_f32_bf16 v39, v73, v29
    v_dot2c_f32_bf16 v40, v74, v21
    v_dot2c_f32_bf16 v41, v74, v29
    v_dot2c_f32_bf16 v42, v75, v21
    v_dot2c_f32_bf16 v43, v75, v29
    v_dot2c_f32_bf16 v44, v76, v21
    v_dot2c_f32_bf16 v45, v76, v29
    v_dot2c_f32_bf16 v46, v77, v21
    v_dot2c_f32_bf16 v47, v77, v29
    v_dot2c_f32_bf16 v48, v78, v21
    v_dot2c_f32_bf16 v49, v78, v29
    v_dot2c_f32_bf16 v50, v79, v21
    v_dot2c_f32_bf16 v51, v79, v29
    v_dot2c_f32_bf16 v52, v80, v21
    v_dot2c_f32_bf16 v53, v80, v29
    v_dot2c_f32_bf16 v54, v81, v21
    v_dot2c_f32_bf16 v55, v81, v29
    v_dot2c_f32_bf16 v56, v82, v21
    v_dot2c_f32_bf16 v57, v82, v29
    v_dot2c_f32_bf16 v58, v83, v21
    v_dot2c_f32_bf16 v59, v83, v29
    s_waitcnt vmcnt(15)
    v_dot2c_f32_bf16 v36, v84, v22
    v_dot2c_f32_bf16 v37, v84, v30
    v_dot2c_f32_bf16 v38, v85, v22
    v_dot2c_f32_bf16 v39, v85, v30
    v_dot2c_f32_bf16 v40, v86, v22
    v_dot2c_f32_bf16 v41, v86, v30
    v_dot2c_f32_bf16 v42, v87, v22
    v_dot2c_f32_bf16 v43, v87, v30
    v_dot2c_f32_bf16 v44, v88, v22
    v_dot2c_f32_bf16 v45, v88, v30
    v_dot2c_f32_bf16 v46, v89, v22
    v_dot2c_f32_bf16 v47, v89, v30
    v_dot2c_f32_bf16 v48, v90, v22
    v_dot2c_f32_bf16 v49, v90, v30
    v_dot2c_f32_bf16 v50, v91, v22
    v_dot2c_f32_bf16 v51, v91, v30
    v_dot2c_f32_bf16 v52, v92, v22
    v_dot2c_f32_bf16 v53, v92, v30
    v_dot2c_f32_bf16 v54, v93, v22
    v_dot2c_f32_bf16 v55, v93, v30
    v_dot2c_f32_bf16 v56, v94, v22
    v_dot2c_f32_bf16 v57, v94, v30
    v_dot2c_f32_bf16 v58, v95, v22
    v_dot2c_f32_bf16 v59, v95, v30
    s_waitcnt vmcnt(12)
    v_dot2c_f32_bf16 v36, v96, v23
    v_dot2c_f32_bf16 v37, v96, v31
    v_dot2c_f32_bf16 v38, v97, v23
    v_dot2c_f32_bf16 v39, v97, v31
    v_dot2c_f32_bf16 v40, v98, v23
    v_dot2c_f32_bf16 v41, v98, v31
    v_dot2c_f32_bf16 v42, v99, v23
    v_dot2c_f32_bf16 v43, v99, v31
    v_dot2c_f32_bf16 v44, v100, v23
    v_dot2c_f32_bf16 v45, v100, v31
    v_dot2c_f32_bf16 v46, v101, v23
    v_dot2c_f32_bf16 v47, v101, v31
    v_dot2c_f32_bf16 v48, v102, v23
    v_dot2c_f32_bf16 v49, v102, v31
    v_dot2c_f32_bf16 v50, v103, v23
    v_dot2c_f32_bf16 v51, v103, v31
    v_dot2c_f32_bf16 v52, v104, v23
    v_dot2c_f32_bf16 v53, v104, v31
    v_dot2c_f32_bf16 v54, v105, v23
    v_dot2c_f32_bf16 v55, v105, v31
    v_dot2c_f32_bf16 v56, v106, v23
    v_dot2c_f32_bf16 v57, v106, v31
    v_dot2c_f32_bf16 v58, v107, v23
    v_dot2c_f32_bf16 v59, v107, v31
    s_waitcnt vmcnt(9)
    v_dot2c_f32_bf16 v36, v108, v24
    v_dot2c_f32_bf16 v37, v108, v32
    v_dot2c_f32_bf16 v38, v109, v24
    v_dot2c_f32_bf16 v39, v109, v32
    v_dot2c_f32_bf16 v40, v110, v24
    v_dot2c_f32_bf16 v41, v110, v32
    v_dot2c_f32_bf16 v42, v111, v24
    v_dot2c_f32_bf16 v43, v111, v32
    v_dot2c_f32_bf16 v44, v112, v24
    v_dot2c_f32_bf16 v45, v112, v32
    v_dot2c_f32_bf16 v46, v113, v24
    v_dot2c_f32_bf16 v47, v113, v32
    v_dot2c_f32_bf16 v48, v114, v24
    v_dot2c_f32_bf16 v49, v114, v32
    v_dot2c_f32_bf16 v50, v115, v24
    v_dot2c_f32_bf16 v51, v115, v32
    v_dot2c_f32_bf16 v52, v116, v24
    v_dot2c_f32_bf16 v53, v116, v32
    v_dot2c_f32_bf16 v54, v117, v24
    v_dot2c_f32_bf16 v55, v117, v32
    v_dot2c_f32_bf16 v56, v118, v24
    v_dot2c_f32_bf16 v57, v118, v32
    v_dot2c_f32_bf16 v58, v119, v24
    v_dot2c_f32_bf16 v59, v119, v32
    s_waitcnt vmcnt(6)
    v_dot2c_f32_bf16 v36, v120, v25
    v_dot2c_f32_bf16 v37, v120, v33
    v_dot2c_f32_bf16 v38, v121, v25
    v_dot2c_f32_bf16 v39, v121, v33
    v_dot2c_f32_bf16 v40, v122, v25
    v_dot2c_f32_bf16 v41, v122, v33
    v_dot2c_f32_bf16 v42, v123, v25
    v_dot2c_f32_bf16 v43, v123, v33
    v_dot2c_f32_bf16 v44, v124, v25
    v_dot2c_f32_bf16 v45, v124, v33
    v_dot2c_f32_bf16 v46, v125, v25
    v_dot2c_f32_bf16 v47, v125, v33
    v_dot2c_f32_bf16 v48, v126, v25
    v_dot2c_f32_bf16 v49, v126, v33
    v_dot2c_f32_bf16 v50, v127, v25
    v_dot2c_f32_bf16 v51, v127, v33
    v_dot2c_f32_bf16 v52, v128, v25
    v_dot2c_f32_bf16 v53, v128, v33
    v_dot2c_f32_bf16 v54, v129, v25
    v_dot2c_f32_bf16 v55, v129, v33
    v_dot2c_f32_bf16 v56, v130, v25
    v_dot2c_f32_bf16 v57, v130, v33
    v_dot2c_f32_bf16 v58, v131, v25
    v_dot2c_f32_bf16 v59, v131, v33
    s_waitcnt vmcnt(3)
    v_dot2c_f32_bf16 v36, v132, v26
    v_dot2c_f32_bf16 v37, v132, v34
    v_dot2c_f32_bf16 v38, v133, v26
    v_dot2c_f32_bf16 v39, v133, v34
    v_dot2c_f32_bf16 v40, v134, v26
    v_dot2c_f32_bf16 v41, v134, v34
    v_dot2c_f32_bf16 v42, v135, v26
    v_dot2c_f32_bf16 v43, v135, v34
    v_dot2c_f32_bf16 v44, v136, v26
    v_dot2c_f32_bf16 v45, v136, v34
    v_dot2c_f32_bf16 v46, v137, v26
    v_dot2c_f32_bf16 v47, v137, v34
    v_dot2c_f32_bf16 v48, v138, v26
    v_dot2c_f32_bf16 v49, v138, v34
    v_dot2c_f32_bf16 v50, v139, v26
    v_dot2c_f32_bf16 v51, v139, v34
    v_dot2c_f32_bf16 v52, v140, v26
    v_dot2c_f32_bf16 v53, v140, v34
    v_dot2c_f32_bf16 v54, v141, v26
    v_dot2c_f32_bf16 v55, v141, v34
    v_dot2c_f32_bf16 v56, v142, v26
    v_dot2c_f32_bf16 v57, v142, v34
    v_dot2c_f32_bf16 v58, v143, v26
    v_dot2c_f32_bf16 v59, v143, v34
    s_waitcnt vmcnt(0)
    v_dot2c_f32_bf16 v36, v144, v27
    v_dot2c_f32_bf16 v37, v144, v35
    v_dot2c_f32_bf16 v38, v145, v27
    v_dot2c_f32_bf16 v39, v145, v35
    v_dot2c_f32_bf16 v40, v146, v27
    v_dot2c_f32_bf16 v41, v146, v35
    v_dot2c_f32_bf16 v42, v147, v27
    v_dot2c_f32_bf16 v43, v147, v35
    v_dot2c_f32_bf16 v44, v148, v27
    v_dot2c_f32_bf16 v45, v148, v35
    v_dot2c_f32_bf16 v46, v149, v27
    v_dot2c_f32_bf16 v47, v149, v35
    v_dot2c_f32_bf16 v48, v150, v27
    v_dot2c_f32_bf16 v49, v150, v35
    v_dot2c_f32_bf16 v50, v151, v27
    v_dot2c_f32_bf16 v51, v151, v35
    v_dot2c_f32_bf16 v52, v152, v27
    v_dot2c_f32_bf16 v53, v152, v35
    v_dot2c_f32_bf16 v54, v153, v27
    v_dot2c_f32_bf16 v55, v153, v35
    v_dot2c_f32_bf16 v56, v154, v27
    v_dot2c_f32_bf16 v57, v154, v35
    v_dot2c_f32_bf16 v58, v155, v27
    v_dot2c_f32_bf16 v59, v155, v35
    v_permlane32_swap_b32 v36, v48
    v_permlane32_swap_b32 v37, v49
    v_permlane32_swap_b32 v38, v50
    v_permlane32_swap_b32 v39, v51
    v_permlane32_swap_b32 v40, v52
    v_permlane32_swap_b32 v41, v53
    v_permlane32_swap_b32 v42, v54
    v_permlane32_swap_b32 v43, v55
    v_permlane32_swap_b32 v44, v56
    v_permlane32_swap_b32 v45, v57
    v_permlane32_swap_b32 v46, v58
    v_permlane32_swap_b32 v47, v59
    v_add_f32 v36, v36, v48
    v_add_f32 v37, v37, v49
    v_add_f32 v38, v38, v50
    v_add_f32 v39, v39, v51
    v_add_f32 v40, v40, v52
    v_add_f32 v41, v41, v53
    v_add_f32 v42, v42, v54
    v_add_f32 v43, v43, v55
    v_add_f32 v44, v44, v56
    v_add_f32 v45, v45, v57
    v_add_f32 v46, v46, v58
    v_add_f32 v47, v47, v59
    v_permlane16_swap_b32 v36, v42
    v_permlane16_swap_b32 v37, v43
    v_permlane16_swap_b32 v38, v44
    v_permlane16_swap_b32 v39, v45
    v_permlane16_swap_b32 v40, v46
    v_permlane16_swap_b32 v41, v47
    v_add_f32 v36, v36, v42
    v_add_f32 v37, v37, v43
    v_add_f32 v38, v38, v44
    v_add_f32 v39, v39, v45
    v_add_f32 v40, v40, v46
    v_add_f32 v41, v41, v47
    v_add_f32_dpp v36, v36, v36 row_ror:8 row_mask:0xf bank_mask:0xf
    v_add_f32_dpp v37, v37, v37 row_ror:8 row_mask:0xf bank_mask:0xf
    v_add_f32_dpp v38, v38, v38 row_ror:8 row_mask:0xf bank_mask:0xf
    v_add_f32_dpp v39, v39, v39 row_ror:8 row_mask:0xf bank_mask:0xf
    v_add_f32_dpp v40, v40, v40 row_ror:8 row_mask:0xf bank_mask:0xf
    v_add_f32_dpp v41, v41, v41 row_ror:8 row_mask:0xf bank_mask:0xf
    v_add_f32_dpp v4, v4, v4 row_ror:8 row_mask:0xf bank_mask:0xf
    v_mov_b32 v5, v4
    s_nop 1
    v_permlane16_swap_b32 v4, v5
    v_add_f32 v4, v4, v5
    v_mov_b32 v5, v4
    s_nop 1
    v_permlane32_swap_b32 v4, v5
    v_add_f32 v4, v4, v5
    v_bfe_u32 v5, v0, 4, 1
    v_mul_u32_u24 v5, 192, v5
    v_lshrrev_b32 v6, 5, v0
    v_mul_u32_u24 v6, 384, v6
    v_add_u32 v5, v5, v6
    v_and_b32 v6, 7, v0
    v_lshlrev_b32 v6, 2, v6
    v_add_u32 v5, v5, v6
    s_mul_i32 s32, s28, 768
    s_add_u32 s32, s32, 16896
    v_add_u32 v5, s32, v5
    ds_write_b32 v5, v36
    ds_write_b32 v5, v37 offset:32
    ds_write_b32 v5, v38 offset:64
    ds_write_b32 v5, v39 offset:96
    ds_write_b32 v5, v40 offset:128
    ds_write_b32 v5, v41 offset:160
    s_lshl_b32 s32, s28, 3
    s_add_u32 s32, s32, 19968
    v_mov_b32 v6, s32
    v_mov_b32 v8, v3
    v_mov_b32 v9, v4
    ds_write_b64 v6, v[8:9]
    s_waitcnt lgkmcnt(0)
    s_barrier
    s_cmp_ge_u32 s28, 3
    s_cbranch_scc1 L_fin
    s_lshl_b32 s32, s28, 6
    v_add_u32 v0, s32, v0
    v_lshrrev_b32 v5, 6, v0
    v_lshlrev_b32 v5, 3, v5
    v_and_b32 v6, 7, v0
    v_add_u32 v5, v5, v6
    v_lshlrev_b32 v5, 3, v5
    v_bfe_u32 v6, v0, 3, 3
    v_add_u32 v5, v5, v6
    v_lshlrev_b32 v5, 2, v5
    v_add_u32 v5, 16896, v5
    v_mov_b32 v6, 19968
    ds_read_b128 v[60:63], v6
    ds_read_b128 v[64:67], v6 offset:16
    ds_read_b32 v68, v5
    ds_read_b32 v69, v5 offset:768
    ds_read_b32 v70, v5 offset:1536
    ds_read_b32 v71, v5 offset:2304
    s_waitcnt lgkmcnt(0)
    v_mov_b32 v3, v60
    v_max_f32 v3, v3, v62
    v_max_f32 v3, v3, v64
    v_max_f32 v3, v3, v66
    v_sub_f32 v60, v60, v3
    v_sub_f32 v62, v62, v3
    v_sub_f32 v64, v64, v3
    v_sub_f32 v66, v66, v3
    v_exp_f32 v60, v60
    v_exp_f32 v62, v62
    v_exp_f32 v64, v64
    v_exp_f32 v66, v66
    v_mul_f32 v4, v60, v61
    v_mul_f32 v8, v60, v68
    v_fmac_f32 v4, v62, v63
    v_fmac_f32 v8, v62, v69
    v_fmac_f32 v4, v64, v65
    v_fmac_f32 v8, v64, v70
    v_fmac_f32 v4, v66, v67
    v_fmac_f32 v8, v66, v71
    v_rcp_f32 v4, v4
    s_nop 0
    v_mul_f32 v8, v8, v4
    v_cvt_pk_bf16_f32 v8, v8, v8
    v_lshlrev_b32 v5, 1, v0
    buffer_store_short v8, v5, s[24:27], 0 offen
L_fin:
L_end:
    s_endpgm
.section .rodata,"a"
.p2align 6
.amdhsa_kernel standalone__softmax_full_bidir__sampling_kernel
  .amdhsa_next_free_vgpr 160
  .amdhsa_next_free_sgpr 64
  .amdhsa_accum_offset 160
  .amdhsa_group_segment_fixed_size 0
  .amdhsa_kernarg_size 48
  .amdhsa_user_sgpr_count 2
  .amdhsa_user_sgpr_kernarg_segment_ptr 1
  .amdhsa_system_sgpr_workgroup_id_x 1
.end_amdhsa_kernel
```
